```python
import torch

def _softmax(x, axis=-1):
    return torch.softmax(x, dim=axis)
def _gelu(x):
    return torch.nn.functional.gelu(x, approximate="tanh")
def _silu(x):
    return torch.nn.functional.silu(x)
def _sigmoid(x):
    return torch.sigmoid(x)
def _layernorm(x, axis=-1, eps=1e-5):
    m = x.mean(dim=axis, keepdim=True)
    v = x.var(dim=axis, keepdim=True, unbiased=False)
    return (x - m) / torch.sqrt(v + eps)
def _scatter_add(tgt, idx, src, axis=0):
    return tgt.clone().index_add_(axis, idx, src)
def _segment_sum(src, seg, n):
    out = torch.zeros((n,) + src.shape[1:], dtype=src.dtype)
    return out.index_add_(0, seg, src)
def _pad(x, pw):
    flat = tuple(v for pair in reversed(pw) for v in pair)
    return torch.nn.functional.pad(x, flat)

kernel_name = 'standalone__gqa_softmax__sampling'

def setup_inputs():

    _w = (lambda a: (lambda t: t.to(torch.bfloat16) if t.is_floating_point() else t)(torch.as_tensor(a)))
    B, Hq, Hkv, Sq, Sk, D = 16, 32, 16, 8, 4096, 128
    return {
        "q": _w((lambda *s: torch.randn(*s, dtype=torch.bfloat16) * 0.8)(B, Hq, Sq, D)),
        "k": _w((lambda *s: torch.randn(*s, dtype=torch.bfloat16) * 0.8)(B, Hkv, Sk, D)),
        "v": _w((lambda *s: torch.randn(*s, dtype=torch.bfloat16) * 0.05)(B, Hkv, Sk, D)),
    }

def reference(q, k, v):
    B, Hq, Sq, D = q.shape
    Hkv = k.shape[1]
    rep = Hq // Hkv
    k = (lambda x, n, axis: torch.repeat_interleave(x, n, dim=axis))(k, rep, axis=1)
    v = (lambda x, n, axis: torch.repeat_interleave(x, n, dim=axis))(v, rep, axis=1)
    scale = D ** -0.5
    scores = torch.einsum("bhqd,bhkd->bhqk", q, k) * scale
    p = _softmax(scores, axis=-1)
    return torch.einsum("bhqk,bhkd->bhqd", p, v)
```

```asm
; @launch grid=(256,1,1) block=(256,1,1) lds=155648
.amdgcn_target "amdgcn-amd-amdhsa--gfx950"
.text
.globl standalone__gqa_softmax__sampling_kernel
.p2align 8
.type standalone__gqa_softmax__sampling_kernel,@function
standalone__gqa_softmax__sampling_kernel:
    s_load_dwordx8 s[4:11], s[0:1], 0
    s_load_dwordx2 s[68:69], s[0:1], 32
    s_cmp_ge_u32 s2, 256
    s_cbranch_scc1 L_end
    v_lshrrev_b32 v1, 6, v0
    v_and_b32 v4, 63, v0
    v_readfirstlane_b32 s28, v1
    v_lshlrev_b32 v2, 4, v4
    v_lshrrev_b32 v9, 4, v4
    v_and_b32 v8, 15, v4
    v_lshlrev_b32 v1, 8, v8
    v_lshl_add_u32 v1, v9, 4, v1
    s_mov_b32 s3, 0
    s_bfe_u32 s36, s2, 0x10000
    s_lshl_b32 s36, s36, 2
    s_or_b32 s3, s3, s36
    s_bfe_u32 s36, s2, 0x10001
    s_lshl_b32 s36, s36, 4
    s_or_b32 s3, s3, s36
    s_bfe_u32 s36, s2, 0x10002
    s_lshl_b32 s36, s36, 7
    s_or_b32 s3, s3, s36
    s_bfe_u32 s36, s2, 0x10003
    s_lshl_b32 s36, s36, 0
    s_or_b32 s3, s3, s36
    s_bfe_u32 s36, s2, 0x10004
    s_lshl_b32 s36, s36, 1
    s_or_b32 s3, s3, s36
    s_bfe_u32 s36, s2, 0x10005
    s_lshl_b32 s36, s36, 3
    s_or_b32 s3, s3, s36
    s_bfe_u32 s36, s2, 0x10006
    s_lshl_b32 s36, s36, 5
    s_or_b32 s3, s3, s36
    s_bfe_u32 s36, s2, 0x10007
    s_lshl_b32 s36, s36, 6
    s_or_b32 s3, s3, s36
    s_mov_b32 s2, s3
    s_lshl_b32 s36, s2, 20
    s_mul_i32 s29, s28, 8192
    s_add_u32 s31, s29, 4096
    s_lshl_b32 s39, s2, 12
    s_mov_b32 s14, 0x100000
    s_mov_b32 s15, 0x20000
    s_mov_b32 s22, 4096
    s_mov_b32 s23, 0x20000
    s_waitcnt lgkmcnt(0)
    s_add_u32 s12, s6, s36
    s_addc_u32 s13, s7, 0
    s_add_u32 s20, s4, s39
    s_addc_u32 s21, s5, 0
    buffer_load_dwordx4 v[108:111], v2, s[12:15], s29 offen offset:0 nt
    buffer_load_dwordx4 v[28:31], v1, s[20:23], 0 offen offset:0
    buffer_load_dwordx4 v[32:35], v1, s[20:23], 0 offen offset:64
    buffer_load_dwordx4 v[36:39], v1, s[20:23], 0 offen offset:128
    buffer_load_dwordx4 v[40:43], v1, s[20:23], 0 offen offset:192
    buffer_load_dwordx4 v[112:115], v2, s[12:15], s29 offen offset:1024 nt
    buffer_load_dwordx4 v[116:119], v2, s[12:15], s29 offen offset:2048 nt
    buffer_load_dwordx4 v[120:123], v2, s[12:15], s29 offen offset:3072 nt
    buffer_load_dwordx4 v[124:127], v2, s[12:15], s31 offen offset:0 nt
    buffer_load_dwordx4 v[128:131], v2, s[12:15], s31 offen offset:1024 nt
    buffer_load_dwordx4 v[132:135], v2, s[12:15], s31 offen offset:2048 nt
    buffer_load_dwordx4 v[136:139], v2, s[12:15], s31 offen offset:3072 nt
    s_mov_b32 s30, s29
    s_add_u32 s30, s30, 32768
    s_add_u32 s31, s30, 4096
    s_add_u32 s16, s8, s36
    s_addc_u32 s17, s9, 0
    s_add_u32 s24, s10, s39
    s_addc_u32 s25, s11, 0
    s_mov_b32 s26, 4096
    s_mov_b32 s27, 0x20000
    s_mov_b32 s33, 0x3e0293ee
    s_mov_b32 s34, 0x05040100
    s_mov_b32 s35, 0x07060302
    s_lshl_b32 s37, s28, 12
    s_add_u32 s37, s37, 139264
    v_lshlrev_b32 v12, 2, v9
    v_xor_b32 v12, v8, v12
    v_lshl_add_u32 v13, v9, 8, s37
    v_xor_b32 v204, 0, v12
    v_lshl_add_u32 v204, v204, 4, v13
    v_xor_b32 v205, 1, v12
    v_lshl_add_u32 v205, v205, 4, v13
    v_xor_b32 v206, 2, v12
    v_lshl_add_u32 v206, v206, 4, v13
    v_xor_b32 v207, 3, v12
    v_lshl_add_u32 v207, v207, 4, v13
    v_and_b32 v12, 3, v8
    v_lshlrev_b32 v12, 2, v12
    v_lshrrev_b32 v13, 2, v8
    v_add_u32 v12, v12, v13
    v_lshl_add_u32 v12, v12, 8, s37
    v_xor_b32 v13, v8, v9
    v_xor_b32 v208, 0, v13
    v_lshl_add_u32 v208, v208, 4, v12
    v_xor_b32 v209, 4, v13
    v_lshl_add_u32 v209, v209, 4, v12
    v_xor_b32 v210, 8, v13
    v_lshl_add_u32 v210, v210, 4, v12
    v_xor_b32 v211, 12, v13
    v_lshl_add_u32 v211, v211, 4, v12
    v_mov_b32 v6, 0xff800000
    v_mov_b32 v7, 0
    v_mov_b32 v44, 0
    v_mov_b32 v45, 0
    v_mov_b32 v46, 0
    v_mov_b32 v47, 0
    v_mov_b32 v48, 0
    v_mov_b32 v49, 0
    v_mov_b32 v50, 0
    v_mov_b32 v51, 0
    v_mov_b32 v52, 0
    v_mov_b32 v53, 0
    v_mov_b32 v54, 0
    v_mov_b32 v55, 0
    v_mov_b32 v56, 0
    v_mov_b32 v57, 0
    v_mov_b32 v58, 0
    v_mov_b32 v59, 0
    v_mov_b32 v60, 0
    v_mov_b32 v61, 0
    v_mov_b32 v62, 0
    v_mov_b32 v63, 0
    v_mov_b32 v64, 0
    v_mov_b32 v65, 0
    v_mov_b32 v66, 0
    v_mov_b32 v67, 0
    v_mov_b32 v68, 0
    v_mov_b32 v69, 0
    v_mov_b32 v70, 0
    v_mov_b32 v71, 0
    v_mov_b32 v72, 0
    v_mov_b32 v73, 0
    v_mov_b32 v74, 0
    v_mov_b32 v75, 0
    s_lshl_b32 s36, s28, 15
    v_lshl_add_u32 v212, v4, 4, s36
    s_lshl_b32 s37, s28, 11
    s_add_u32 s37, s37, 131072
    v_lshl_add_u32 v213, v8, 2, s37
    v_mul_u32_u24 v214, 528, v8
    v_lshl_add_u32 v214, v9, 7, v214
    v_add_u32 v214, s36, v214
    s_add_u32 s36, s36, 8448
    v_lshl_add_u32 v215, v8, 3, s36
    v_lshrrev_b32 v12, 4, v0
    v_lshlrev_b32 v216, 3, v12
    v_add_u32 v216, 8448, v216
    s_lshl_b32 s36, s28, 12
    v_lshlrev_b32 v216, 3, v8
    v_add_u32 v216, 139264, v216
    v_add_u32 v215, s36, v216
    v_mul_u32_u24 v217, 528, v12
    v_lshl_add_u32 v217, v8, 5, v217
    v_lshlrev_b32 v218, 4, v0
    s_mov_b32 s38, 16
    s_mov_b32 s44, 0
    s_mov_b32 s45, 1
    s_getreg_b32 s58, hwreg(HW_REG_XCC_ID)
    s_mov_b32 s61, 96
    s_bitcmp1_b32 s58, 0
    s_cselect_b32 s61, 110, s61
    s_mov_b32 s70, 128
    s_mov_b32 s71, 0x20000
    v_lshlrev_b32 v14, 1, v4
    s_getreg_b32 s58, hwreg(HW_REG_HW_ID)
    s_bfe_u32 s59, s58, 0x2000d
    s_bfe_u32 s58, s58, 0x30008
    s_lshl_b32 s59, s59, 3
    s_add_u32 s58, s58, s59
    s_lshl_b32 s58, s58, 2
    s_add_u32 s58, s58, s28
    v_lshlrev_b32 v15, 12, v4
    v_add_u32 v15, s58, v15
    s_mov_b32 s62, 0
    s_mov_b32 s60, 1
L_kloop:
    buffer_load_ushort v5, v14, s[68:71], 0 offen
    s_add_u32 s62, s62, 1
    v_mov_b32 v1, s62
    buffer_store_byte v1, v15, s[68:71], 0 offen
    s_cmp_lg_u32 s60, 0
    s_waitcnt vmcnt(7)
    s_cbranch_scc1 L_k0
    s_waitcnt vmcnt(6)
L_k0:
    buffer_load_dwordx4 v[140:143], v2, s[12:15], s30 offen offset:0 nt
    s_cmp_eq_u32 s38, 16
    s_cbranch_scc1 L_first0
    s_waitcnt lgkmcnt(0)
    v_mfma_f32_16x16x32_bf16 v[96:99], v[76:79], v[28:31], 0
    v_mfma_f32_16x16x32_bf16 v[96:99], v[80:83], v[32:35], v[96:99]
    v_mfma_f32_16x16x32_bf16 v[96:99], v[84:87], v[36:39], v[96:99]
    v_mfma_f32_16x16x32_bf16 v[96:99], v[88:91], v[40:43], v[96:99]
L_first0:
    s_cmp_lg_u32 s60, 0
    ds_write_b128 v204, v[108:111] offset:0
    s_waitcnt vmcnt(7)
    s_cbranch_scc1 L_k1
    s_waitcnt vmcnt(6)
L_k1:
    buffer_load_dwordx4 v[144:147], v2, s[12:15], s30 offen offset:1024 nt
    s_cmp_eq_u32 s38, 16
    s_cbranch_scc1 L_first1
    v_max3_f32 v8, v92, v93, v94
    v_max3_f32 v9, v96, v97, v98
    v_max3_f32 v8, v8, v95, v6
    v_max3_f32 v8, v8, v9, v99
    v_mov_b32 v9, v8
    s_nop 1
    v_permlane32_swap_b32 v8, v9
    v_max_f32 v8, v8, v9
    v_mov_b32 v9, v8
    s_nop 1
    v_permlane16_swap_b32 v8, v9
    v_max_f32 v8, v8, v9
    v_mul_f32 v10, s33, v8
L_first1:
    s_cmp_lg_u32 s60, 0
    ds_write_b128 v205, v[112:115] offset:1024
    s_waitcnt vmcnt(7)
    s_cbranch_scc1 L_k2
    s_waitcnt vmcnt(6)
L_k2:
    buffer_load_dwordx4 v[148:151], v2, s[12:15], s30 offen offset:2048 nt
    s_cmp_eq_u32 s38, 16
    s_cbranch_scc1 L_first2
    v_fma_f32 v92, v92, s33, -v10
    v_fma_f32 v93, v93, s33, -v10
    v_fma_f32 v94, v94, s33, -v10
    v_fma_f32 v95, v95, s33, -v10
    v_fma_f32 v96, v96, s33, -v10
    v_fma_f32 v97, v97, s33, -v10
    v_fma_f32 v98, v98, s33, -v10
    v_fma_f32 v99, v99, s33, -v10
    v_exp_f32 v92, v92
    v_exp_f32 v93, v93
    v_exp_f32 v94, v94
    v_exp_f32 v95, v95
    v_exp_f32 v96, v96
    v_exp_f32 v97, v97
    v_exp_f32 v98, v98
    v_exp_f32 v99, v99
L_first2:
    s_cmp_lg_u32 s60, 0
    ds_write_b128 v206, v[116:119] offset:2048
    s_waitcnt vmcnt(7)
    s_cbranch_scc1 L_k3
    s_waitcnt vmcnt(6)
L_k3:
    buffer_load_dwordx4 v[152:155], v2, s[12:15], s30 offen offset:3072 nt
    s_cmp_eq_u32 s38, 16
    s_cbranch_scc1 L_first3
    v_cmp_gt_f32 vcc, v8, v6
    s_cbranch_vccz L_nrb
    v_fma_f32 v11, v6, s33, -v10
    v_exp_f32 v11, v11
    v_mov_b32 v6, v8
    s_or_b32 s44, s44, s45
    v_mul_f32 v7, v11, v7
    ds_write_b32 v213, v11 offset:64
L_nrb:
    s_lshl_b32 s45, s45, 1
    s_cmp_lg_u32 s60, 0
L_first3:
    s_cmp_lg_u32 s60, 0
    ds_write_b128 v207, v[120:123] offset:3072
    ds_read_b128 v[76:79], v208
    ds_read_b128 v[80:83], v209
    ds_read_b128 v[84:87], v210
    ds_read_b128 v[88:91], v211
    s_waitcnt vmcnt(7)
    s_cbranch_scc1 L_k4
    s_waitcnt vmcnt(5)
L_k4:
    buffer_load_dwordx4 v[156:159], v2, s[12:15], s31 offen offset:0 nt
    s_waitcnt lgkmcnt(0)
    v_mfma_f32_16x16x32_bf16 v[20:23], v[76:79], v[28:31], 0
    v_mfma_f32_16x16x32_bf16 v[20:23], v[80:83], v[32:35], v[20:23]
    v_mfma_f32_16x16x32_bf16 v[20:23], v[84:87], v[36:39], v[20:23]
    v_mfma_f32_16x16x32_bf16 v[20:23], v[88:91], v[40:43], v[20:23]
    s_cmp_eq_u32 s38, 16
    s_cbranch_scc1 L_first4
    v_add_f32 v9, v92, v93
    v_add_f32 v12, v94, v95
    v_add_f32 v13, v96, v97
    v_add_f32 v7, v7, v98
    v_add_f32 v9, v9, v12
    v_add_f32 v13, v13, v99
    v_add_f32 v7, v7, v9
    v_add_f32 v7, v7, v13
    v_cvt_pk_bf16_f32 v16, v92, v93
    v_cvt_pk_bf16_f32 v17, v94, v95
    v_cvt_pk_bf16_f32 v18, v96, v97
    v_cvt_pk_bf16_f32 v19, v98, v99
    ds_write_b128 v212, v[16:19] offset:1024
    v_add_u32 v212, 2048, v212
    v_add_u32 v213, 128, v213
L_first4:
    s_cmp_lg_u32 s60, 0
    ds_write_b128 v204, v[124:127] offset:0
    s_waitcnt vmcnt(6)
    s_cbranch_scc1 L_k5
    s_waitcnt vmcnt(4)
L_k5:
    buffer_load_dwordx4 v[160:163], v2, s[12:15], s31 offen offset:1024 nt
    ds_write_b128 v205, v[128:131] offset:1024
    s_waitcnt vmcnt(5)
    s_cbranch_scc1 L_k6
    s_waitcnt vmcnt(4)
L_k6:
    buffer_load_dwordx4 v[164:167], v2, s[12:15], s31 offen offset:2048 nt
    ds_write_b128 v206, v[132:135] offset:2048
    s_waitcnt vmcnt(5)
    s_cbranch_scc1 L_k7
    s_waitcnt vmcnt(4)
L_k7:
    buffer_load_dwordx4 v[168:171], v2, s[12:15], s31 offen offset:3072 nt
    ds_write_b128 v207, v[136:139] offset:3072
    ds_read_b128 v[76:79], v208
    ds_read_b128 v[80:83], v209
    ds_read_b128 v[84:87], v210
    ds_read_b128 v[88:91], v211
    v_and_b32 v1, 0xff, v5
    v_lshrrev_b32 v5, 8, v5
    v_cmp_le_u32 vcc, s62, v1
    v_cmp_le_u32 s[66:67], s62, v5
    s_bcnt1_i32_b64 s63, vcc
    s_bcnt1_i32_b64 s59, s[66:67]
    s_add_u32 s63, s63, s59
    s_cmp_le_u32 s62, 2
    s_cselect_b32 s63, 0xff, s63
    s_cmp_ge_u32 s63, s61
    s_cselect_b32 s60, 1, 0
    s_add_u32 s30, s30, 32768
    s_add_u32 s31, s30, 4096
    s_cmp_lg_u32 s38, 1
    s_cbranch_scc1 L_noswitch
    s_mov_b32 s12, s16
    s_mov_b32 s13, s17
    s_mov_b32 s30, s29
    s_add_u32 s31, s29, 4096
L_noswitch:
    buffer_load_ushort v5, v14, s[68:71], 0 offen
    s_add_u32 s62, s62, 1
    v_mov_b32 v1, s62
    buffer_store_byte v1, v15, s[68:71], 0 offen
    s_cmp_lg_u32 s60, 0
    s_waitcnt vmcnt(7)
    s_cbranch_scc1 L_k8
    s_waitcnt vmcnt(6)
L_k8:
    buffer_load_dwordx4 v[108:111], v2, s[12:15], s30 offen offset:0 nt
    s_waitcnt lgkmcnt(0)
    v_mfma_f32_16x16x32_bf16 v[24:27], v[76:79], v[28:31], 0
    v_mfma_f32_16x16x32_bf16 v[24:27], v[80:83], v[32:35], v[24:27]
    v_mfma_f32_16x16x32_bf16 v[24:27], v[84:87], v[36:39], v[24:27]
    v_mfma_f32_16x16x32_bf16 v[24:27], v[88:91], v[40:43], v[24:27]
    ds_write_b128 v204, v[140:143] offset:0
    s_waitcnt vmcnt(7)
    s_cbranch_scc1 L_k9
    s_waitcnt vmcnt(6)
L_k9:
    buffer_load_dwordx4 v[112:115], v2, s[12:15], s30 offen offset:1024 nt
    ds_write_b128 v205, v[144:147] offset:1024
    v_max3_f32 v8, v20, v21, v22
    s_nop 1
    v_max3_f32 v9, v24, v25, v26
    v_max3_f32 v8, v8, v23, v6
    v_max3_f32 v8, v8, v9, v27
    v_mov_b32 v9, v8
    s_nop 1
    v_permlane32_swap_b32 v8, v9
    v_max_f32 v8, v8, v9
    v_mov_b32 v9, v8
    s_nop 1
    v_permlane16_swap_b32 v8, v9
    v_max_f32 v8, v8, v9
    v_mul_f32 v10, s33, v8
    s_waitcnt vmcnt(7)
    s_cbranch_scc1 L_k10
    s_waitcnt vmcnt(6)
L_k10:
    buffer_load_dwordx4 v[116:119], v2, s[12:15], s30 offen offset:2048 nt
    ds_write_b128 v206, v[148:151] offset:2048
    v_fma_f32 v20, v20, s33, -v10
    v_fma_f32 v21, v21, s33, -v10
    v_fma_f32 v22, v22, s33, -v10
    v_fma_f32 v23, v23, s33, -v10
    v_fma_f32 v24, v24, s33, -v10
    v_fma_f32 v25, v25, s33, -v10
    v_fma_f32 v26, v26, s33, -v10
    v_fma_f32 v27, v27, s33, -v10
    v_exp_f32 v20, v20
    v_exp_f32 v21, v21
    v_exp_f32 v22, v22
    v_exp_f32 v23, v23
    v_exp_f32 v24, v24
    v_exp_f32 v25, v25
    v_exp_f32 v26, v26
    v_exp_f32 v27, v27
    s_waitcnt vmcnt(7)
    s_cbranch_scc1 L_k11
    s_waitcnt vmcnt(6)
L_k11:
    buffer_load_dwordx4 v[120:123], v2, s[12:15], s30 offen offset:3072 nt
    ds_write_b128 v207, v[152:155] offset:3072
    ds_read_b128 v[76:79], v208
    ds_read_b128 v[80:83], v209
    ds_read_b128 v[84:87], v210
    ds_read_b128 v[88:91], v211
    v_cmp_gt_f32 vcc, v8, v6
    s_cbranch_vccz L_nra
    v_fma_f32 v11, v6, s33, -v10
    v_exp_f32 v11, v11
    v_mov_b32 v6, v8
    s_or_b32 s44, s44, s45
    v_mul_f32 v7, v11, v7
    ds_write_b32 v213, v11 offset:0
L_nra:
    s_lshl_b32 s45, s45, 1
    s_cmp_lg_u32 s60, 0
    s_waitcnt vmcnt(7)
    s_cbranch_scc1 L_k12
    s_waitcnt vmcnt(5)
L_k12:
    buffer_load_dwordx4 v[124:127], v2, s[12:15], s31 offen offset:0 nt
    s_waitcnt lgkmcnt(0)
    v_mfma_f32_16x16x32_bf16 v[92:95], v[76:79], v[28:31], 0
    v_mfma_f32_16x16x32_bf16 v[92:95], v[80:83], v[32:35], v[92:95]
    v_mfma_f32_16x16x32_bf16 v[92:95], v[84:87], v[36:39], v[92:95]
    v_mfma_f32_16x16x32_bf16 v[92:95], v[88:91], v[40:43], v[92:95]
    ds_write_b128 v204, v[156:159] offset:0
    s_waitcnt vmcnt(6)
    s_cbranch_scc1 L_k13
    s_waitcnt vmcnt(4)
L_k13:
    buffer_load_dwordx4 v[128:131], v2, s[12:15], s31 offen offset:1024 nt
    ds_write_b128 v205, v[160:163] offset:1024
    v_add_f32 v9, v20, v21
    v_add_f32 v12, v22, v23
    v_add_f32 v13, v24, v25
    v_add_f32 v7, v7, v26
    v_add_f32 v9, v9, v12
    v_add_f32 v13, v13, v27
    v_add_f32 v7, v7, v9
    v_add_f32 v7, v7, v13
    v_cvt_pk_bf16_f32 v16, v20, v21
    v_cvt_pk_bf16_f32 v17, v22, v23
    v_cvt_pk_bf16_f32 v18, v24, v25
    v_cvt_pk_bf16_f32 v19, v26, v27
    ds_write_b128 v212, v[16:19] offset:0
    s_waitcnt vmcnt(5)
    s_cbranch_scc1 L_k14
    s_waitcnt vmcnt(4)
L_k14:
    buffer_load_dwordx4 v[132:135], v2, s[12:15], s31 offen offset:2048 nt
    ds_write_b128 v206, v[164:167] offset:2048
    s_waitcnt vmcnt(5)
    s_cbranch_scc1 L_k15
    s_waitcnt vmcnt(4)
L_k15:
    buffer_load_dwordx4 v[136:139], v2, s[12:15], s31 offen offset:3072 nt
    ds_write_b128 v207, v[168:171] offset:3072
    ds_read_b128 v[76:79], v208
    ds_read_b128 v[80:83], v209
    ds_read_b128 v[84:87], v210
    ds_read_b128 v[88:91], v211
    v_and_b32 v1, 0xff, v5
    v_lshrrev_b32 v5, 8, v5
    v_cmp_le_u32 vcc, s62, v1
    v_cmp_le_u32 s[66:67], s62, v5
    s_bcnt1_i32_b64 s63, vcc
    s_bcnt1_i32_b64 s59, s[66:67]
    s_add_u32 s63, s63, s59
    s_cmp_le_u32 s62, 2
    s_cselect_b32 s63, 0xff, s63
    s_cmp_ge_u32 s63, s61
    s_cselect_b32 s60, 1, 0
    s_add_u32 s30, s30, 32768
    s_add_u32 s31, s30, 4096
    s_sub_u32 s38, s38, 1
    s_cmp_lg_u32 s38, 0
    s_cbranch_scc1 L_kloop
    v_subrev_u32 v224, 30720, v212
    v_subrev_u32 v225, 1920, v213
    s_and_b32 s44, s44, -2
    s_mov_b32 s38, 16
L_vloop:
    buffer_load_ushort v5, v14, s[68:71], 0 offen
    s_add_u32 s62, s62, 1
    v_mov_b32 v1, s62
    buffer_store_byte v1, v15, s[68:71], 0 offen
    s_cmp_lg_u32 s60, 0
    ds_read_b128 v[104:107], v224
    ds_read_b32 v3, v225
    ds_read_b128 v[220:223], v224 offset:1024
    ds_read_b32 v219, v225 offset:64
    s_waitcnt vmcnt(7)
    s_cbranch_scc1 L_v0
    s_waitcnt vmcnt(6)
L_v0:
    buffer_load_dwordx4 v[140:143], v2, s[12:15], s30 offen offset:0 nt
    s_cmp_lg_u32 s38, 16
    s_cbranch_scc1 L_lz0
    s_waitcnt lgkmcnt(0)
    v_mfma_f32_16x16x32_bf16 v[96:99], v[76:79], v[28:31], 0
    v_mfma_f32_16x16x32_bf16 v[96:99], v[80:83], v[32:35], v[96:99]
    v_mfma_f32_16x16x32_bf16 v[96:99], v[84:87], v[36:39], v[96:99]
    v_mfma_f32_16x16x32_bf16 v[96:99], v[88:91], v[40:43], v[96:99]
L_lz0:
    s_cmp_lg_u32 s60, 0
    s_waitcnt vmcnt(7)
    s_cbranch_scc1 L_v1
    s_waitcnt vmcnt(6)
L_v1:
    buffer_load_dwordx4 v[144:147], v2, s[12:15], s30 offen offset:1024 nt
    v_perm_b32 v172, v112, v108, s34
    v_perm_b32 v176, v112, v108, s35
    v_perm_b32 v180, v113, v109, s34
    v_perm_b32 v184, v113, v109, s35
    v_perm_b32 v188, v114, v110, s34
    v_perm_b32 v192, v114, v110, s35
    v_perm_b32 v196, v115, v111, s34
    v_perm_b32 v200, v115, v111, s35
    s_waitcnt vmcnt(7)
    s_cbranch_scc1 L_v2
    s_waitcnt vmcnt(6)
L_v2:
    buffer_load_dwordx4 v[148:151], v2, s[12:15], s30 offen offset:2048 nt
    s_cmp_lg_u32 s38, 16
    s_cbranch_scc1 L_lz2
    v_max3_f32 v8, v92, v93, v94
    v_max3_f32 v9, v96, v97, v98
    v_max3_f32 v8, v8, v95, v6
    v_max3_f32 v8, v8, v9, v99
    v_mov_b32 v9, v8
    s_nop 1
    v_permlane32_swap_b32 v8, v9
    v_max_f32 v8, v8, v9
    v_mov_b32 v9, v8
    s_nop 1
    v_permlane16_swap_b32 v8, v9
    v_max_f32 v8, v8, v9
    v_mul_f32 v10, s33, v8
L_lz2:
    s_cmp_lg_u32 s60, 0
    s_cmp_lg_u32 s38, 15
    s_cbranch_scc1 L_eb
    s_waitcnt lgkmcnt(0)
    s_barrier
    ds_read_b64 v[76:77], v216 offset:0
    ds_read_b64 v[78:79], v216 offset:4096
    ds_read_b64 v[80:81], v216 offset:8192
    ds_read_b64 v[82:83], v216 offset:12288
    s_waitcnt lgkmcnt(0)
    v_max3_f32 v8, v76, v78, v80
    v_max_f32 v8, v8, v82
    v_mul_f32 v9, s33, v8
    v_fma_f32 v76, v76, s33, -v9
    v_fma_f32 v78, v78, s33, -v9
    v_fma_f32 v80, v80, s33, -v9
    v_fma_f32 v82, v82, s33, -v9
    v_fma_f32 v229, v6, s33, -v9
    v_exp_f32 v76, v76
    v_exp_f32 v78, v78
    v_exp_f32 v80, v80
    v_exp_f32 v82, v82
    v_exp_f32 v229, v229
    v_mul_f32 v12, v76, v77
    v_fmac_f32 v12, v78, v79
    v_fmac_f32 v12, v80, v81
    v_fmac_f32 v12, v82, v83
    v_rcp_f32 v12, v12
    s_nop 0
    v_mul_f32 v229, v229, v12
L_eb:
    s_cmp_lg_u32 s60, 0
    s_waitcnt vmcnt(7)
    s_cbranch_scc1 L_v3
    s_waitcnt vmcnt(6)
L_v3:
    buffer_load_dwordx4 v[152:155], v2, s[12:15], s30 offen offset:3072 nt
    v_perm_b32 v173, v120, v116, s34
    v_perm_b32 v177, v120, v116, s35
    v_perm_b32 v181, v121, v117, s34
    v_perm_b32 v185, v121, v117, s35
    v_perm_b32 v189, v122, v118, s34
    v_perm_b32 v193, v122, v118, s35
    v_perm_b32 v197, v123, v119, s34
    v_perm_b32 v201, v123, v119, s35
    s_waitcnt vmcnt(7)
    s_cbranch_scc1 L_v4
    s_waitcnt vmcnt(5)
L_v4:
    buffer_load_dwordx4 v[156:159], v2, s[12:15], s31 offen offset:0 nt
    s_cmp_lg_u32 s38, 16
    s_cbranch_scc1 L_lz4
    v_fma_f32 v92, v92, s33, -v10
    v_fma_f32 v93, v93, s33, -v10
    v_fma_f32 v94, v94, s33, -v10
    v_fma_f32 v95, v95, s33, -v10
    v_fma_f32 v96, v96, s33, -v10
    v_fma_f32 v97, v97, s33, -v10
    v_fma_f32 v98, v98, s33, -v10
    v_fma_f32 v99, v99, s33, -v10
    v_exp_f32 v92, v92
    v_exp_f32 v93, v93
    v_exp_f32 v94, v94
    v_exp_f32 v95, v95
    v_exp_f32 v96, v96
    v_exp_f32 v97, v97
    v_exp_f32 v98, v98
    v_exp_f32 v99, v99
L_lz4:
    s_cmp_lg_u32 s60, 0
    s_bitcmp1_b32 s44, 0
    s_cbranch_scc0 L_nv0
    s_waitcnt lgkmcnt(0)
    v_mul_f32 v44, v3, v44
    v_mul_f32 v45, v3, v45
    v_mul_f32 v46, v3, v46
    v_mul_f32 v47, v3, v47
    v_mul_f32 v48, v3, v48
    v_mul_f32 v49, v3, v49
    v_mul_f32 v50, v3, v50
    v_mul_f32 v51, v3, v51
    v_mul_f32 v52, v3, v52
    v_mul_f32 v53, v3, v53
    v_mul_f32 v54, v3, v54
    v_mul_f32 v55, v3, v55
    v_mul_f32 v56, v3, v56
    v_mul_f32 v57, v3, v57
    v_mul_f32 v58, v3, v58
    v_mul_f32 v59, v3, v59
    v_mul_f32 v60, v3, v60
    v_mul_f32 v61, v3, v61
    v_mul_f32 v62, v3, v62
    v_mul_f32 v63, v3, v63
    v_mul_f32 v64, v3, v64
    v_mul_f32 v65, v3, v65
    v_mul_f32 v66, v3, v66
    v_mul_f32 v67, v3, v67
    v_mul_f32 v68, v3, v68
    v_mul_f32 v69, v3, v69
    v_mul_f32 v70, v3, v70
    v_mul_f32 v71, v3, v71
    v_mul_f32 v72, v3, v72
    v_mul_f32 v73, v3, v73
    v_mul_f32 v74, v3, v74
    v_mul_f32 v75, v3, v75
L_nv0:
    s_cmp_lg_u32 s60, 0
    s_waitcnt vmcnt(6)
    s_cbranch_scc1 L_v5
    s_waitcnt vmcnt(4)
L_v5:
    buffer_load_dwordx4 v[160:163], v2, s[12:15], s31 offen offset:1024 nt
    s_cmp_lg_u32 s38, 16
    s_cbranch_scc1 L_lz5
    v_cmp_gt_f32 vcc, v8, v6
    s_cbranch_vccz L_nrc
    v_fma_f32 v11, v6, s33, -v10
    v_exp_f32 v11, v11
    v_mov_b32 v6, v8
    s_or_b32 s44, s44, s45
    v_mul_f32 v7, v11, v7
    ds_write_b32 v213, v11 offset:64
L_nrc:
    s_lshl_b32 s45, s45, 1
    s_cmp_lg_u32 s60, 0
L_lz5:
    s_cmp_lg_u32 s60, 0
    v_perm_b32 v174, v128, v124, s34
    v_perm_b32 v178, v128, v124, s35
    v_perm_b32 v182, v129, v125, s34
    v_perm_b32 v186, v129, v125, s35
    v_perm_b32 v190, v130, v126, s34
    v_perm_b32 v194, v130, v126, s35
    v_perm_b32 v198, v131, v127, s34
    v_perm_b32 v202, v131, v127, s35
    s_waitcnt vmcnt(5)
    s_cbranch_scc1 L_v6
    s_waitcnt vmcnt(4)
L_v6:
    buffer_load_dwordx4 v[164:167], v2, s[12:15], s31 offen offset:2048 nt
    s_cmp_lg_u32 s38, 16
    s_cbranch_scc1 L_lz6
    v_add_f32 v9, v92, v93
    v_add_f32 v12, v94, v95
    v_add_f32 v13, v96, v97
    v_add_f32 v7, v7, v98
    v_add_f32 v9, v9, v12
    v_add_f32 v13, v13, v99
    v_add_f32 v7, v7, v9
    v_add_f32 v7, v7, v13
    v_cvt_pk_bf16_f32 v16, v92, v93
    v_cvt_pk_bf16_f32 v17, v94, v95
    v_cvt_pk_bf16_f32 v18, v96, v97
    v_cvt_pk_bf16_f32 v19, v98, v99
    ds_write_b128 v212, v[16:19] offset:1024
L_lz6:
    s_cmp_lg_u32 s60, 0
    s_waitcnt vmcnt(5)
    s_cbranch_scc1 L_v7
    s_waitcnt vmcnt(4)
L_v7:
    buffer_load_dwordx4 v[168:171], v2, s[12:15], s31 offen offset:3072 nt
    v_perm_b32 v175, v136, v132, s34
    v_perm_b32 v179, v136, v132, s35
    v_perm_b32 v183, v137, v133, s34
    v_perm_b32 v187, v137, v133, s35
    v_perm_b32 v191, v138, v134, s34
    v_perm_b32 v195, v138, v134, s35
    v_perm_b32 v199, v139, v135, s34
    v_perm_b32 v203, v139, v135, s35
    v_and_b32 v1, 0xff, v5
    v_lshrrev_b32 v5, 8, v5
    v_cmp_le_u32 vcc, s62, v1
    v_cmp_le_u32 s[66:67], s62, v5
    s_bcnt1_i32_b64 s63, vcc
    s_bcnt1_i32_b64 s59, s[66:67]
    s_add_u32 s63, s63, s59
    s_cmp_ge_u32 s63, s61
    s_cselect_b32 s60, 1, 0
    s_waitcnt lgkmcnt(0)
    v_mfma_f32_16x16x32_bf16 v[44:47], v[172:175], v[104:107], v[44:47]
    v_mfma_f32_16x16x32_bf16 v[48:51], v[176:179], v[104:107], v[48:51]
    v_mfma_f32_16x16x32_bf16 v[52:55], v[180:183], v[104:107], v[52:55]
    v_mfma_f32_16x16x32_bf16 v[56:59], v[184:187], v[104:107], v[56:59]
    v_mfma_f32_16x16x32_bf16 v[60:63], v[188:191], v[104:107], v[60:63]
    v_mfma_f32_16x16x32_bf16 v[64:67], v[192:195], v[104:107], v[64:67]
    v_mfma_f32_16x16x32_bf16 v[68:71], v[196:199], v[104:107], v[68:71]
    v_mfma_f32_16x16x32_bf16 v[72:75], v[200:203], v[104:107], v[72:75]
    s_add_u32 s30, s30, 32768
    s_add_u32 s31, s30, 4096
    buffer_load_ushort v5, v14, s[68:71], 0 offen
    s_add_u32 s62, s62, 1
    v_mov_b32 v1, s62
    buffer_store_byte v1, v15, s[68:71], 0 offen
    s_cmp_lg_u32 s60, 0
    s_waitcnt vmcnt(7)
    s_cbranch_scc1 L_v8
    s_waitcnt vmcnt(6)
L_v8:
    buffer_load_dwordx4 v[108:111], v2, s[12:15], s30 offen offset:0 nt
    s_waitcnt vmcnt(7)
    s_cbranch_scc1 L_v9
    s_waitcnt vmcnt(6)
L_v9:
    buffer_load_dwordx4 v[112:115], v2, s[12:15], s30 offen offset:1024 nt
    v_perm_b32 v172, v144, v140, s34
    v_perm_b32 v176, v144, v140, s35
    v_perm_b32 v180, v145, v141, s34
    v_perm_b32 v184, v145, v141, s35
    v_perm_b32 v188, v146, v142, s34
    v_perm_b32 v192, v146, v142, s35
    v_perm_b32 v196, v147, v143, s34
    v_perm_b32 v200, v147, v143, s35
    s_waitcnt vmcnt(7)
    s_cbranch_scc1 L_v10
    s_waitcnt vmcnt(6)
L_v10:
    buffer_load_dwordx4 v[116:119], v2, s[12:15], s30 offen offset:2048 nt
    s_cmp_lg_u32 s38, 16
    s_cbranch_scc1 L_ea
    v_mov_b32 v9, v7
    s_nop 1
    v_permlane32_swap_b32 v7, v9
    v_add_f32 v7, v7, v9
    v_mov_b32 v9, v7
    s_nop 1
    v_permlane16_swap_b32 v7, v9
    v_add_f32 v7, v7, v9
    ds_write_b64 v215, v[6:7]
L_ea:
    s_cmp_lg_u32 s60, 0
    s_waitcnt vmcnt(7)
    s_cbranch_scc1 L_v11
    s_waitcnt vmcnt(6)
L_v11:
    buffer_load_dwordx4 v[120:123], v2, s[12:15], s30 offen offset:3072 nt
    v_perm_b32 v173, v152, v148, s34
    v_perm_b32 v177, v152, v148, s35
    v_perm_b32 v181, v153, v149, s34
    v_perm_b32 v185, v153, v149, s35
    v_perm_b32 v189, v154, v150, s34
    v_perm_b32 v193, v154, v150, s35
    v_perm_b32 v197, v155, v151, s34
    v_perm_b32 v201, v155, v151, s35
    s_waitcnt vmcnt(7)
    s_cbranch_scc1 L_v12
    s_waitcnt vmcnt(5)
L_v12:
    buffer_load_dwordx4 v[124:127], v2, s[12:15], s31 offen offset:0 nt
    s_bitcmp1_b32 s44, 1
    s_cbranch_scc0 L_nv1
    s_waitcnt lgkmcnt(0)
    v_mul_f32 v44, v219, v44
    v_mul_f32 v45, v219, v45
    v_mul_f32 v46, v219, v46
    v_mul_f32 v47, v219, v47
    v_mul_f32 v48, v219, v48
    v_mul_f32 v49, v219, v49
    v_mul_f32 v50, v219, v50
    v_mul_f32 v51, v219, v51
    v_mul_f32 v52, v219, v52
    v_mul_f32 v53, v219, v53
    v_mul_f32 v54, v219, v54
    v_mul_f32 v55, v219, v55
    v_mul_f32 v56, v219, v56
    v_mul_f32 v57, v219, v57
    v_mul_f32 v58, v219, v58
    v_mul_f32 v59, v219, v59
    v_mul_f32 v60, v219, v60
    v_mul_f32 v61, v219, v61
    v_mul_f32 v62, v219, v62
    v_mul_f32 v63, v219, v63
    v_mul_f32 v64, v219, v64
    v_mul_f32 v65, v219, v65
    v_mul_f32 v66, v219, v66
    v_mul_f32 v67, v219, v67
    v_mul_f32 v68, v219, v68
    v_mul_f32 v69, v219, v69
    v_mul_f32 v70, v219, v70
    v_mul_f32 v71, v219, v71
    v_mul_f32 v72, v219, v72
    v_mul_f32 v73, v219, v73
    v_mul_f32 v74, v219, v74
    v_mul_f32 v75, v219, v75
L_nv1:
    s_cmp_lg_u32 s60, 0
    s_waitcnt vmcnt(6)
    s_cbranch_scc1 L_v13
    s_waitcnt vmcnt(4)
L_v13:
    buffer_load_dwordx4 v[128:131], v2, s[12:15], s31 offen offset:1024 nt
    v_perm_b32 v174, v160, v156, s34
    v_perm_b32 v178, v160, v156, s35
    v_perm_b32 v182, v161, v157, s34
    v_perm_b32 v186, v161, v157, s35
    v_perm_b32 v190, v162, v158, s34
    v_perm_b32 v194, v162, v158, s35
    v_perm_b32 v198, v163, v159, s34
    v_perm_b32 v202, v163, v159, s35
    s_waitcnt vmcnt(5)
    s_cbranch_scc1 L_v14
    s_waitcnt vmcnt(4)
L_v14:
    buffer_load_dwordx4 v[132:135], v2, s[12:15], s31 offen offset:2048 nt
    s_waitcnt vmcnt(5)
    s_cbranch_scc1 L_v15
    s_waitcnt vmcnt(4)
L_v15:
    buffer_load_dwordx4 v[136:139], v2, s[12:15], s31 offen offset:3072 nt
    v_perm_b32 v175, v168, v164, s34
    v_perm_b32 v179, v168, v164, s35
    v_perm_b32 v183, v169, v165, s34
    v_perm_b32 v187, v169, v165, s35
    v_perm_b32 v191, v170, v166, s34
    v_perm_b32 v195, v170, v166, s35
    v_perm_b32 v199, v171, v167, s34
    v_perm_b32 v203, v171, v167, s35
    v_and_b32 v1, 0xff, v5
    v_lshrrev_b32 v5, 8, v5
    v_cmp_le_u32 vcc, s62, v1
    v_cmp_le_u32 s[66:67], s62, v5
    s_bcnt1_i32_b64 s63, vcc
    s_bcnt1_i32_b64 s59, s[66:67]
    s_add_u32 s63, s63, s59
    s_cmp_ge_u32 s63, s61
    s_cselect_b32 s60, 1, 0
    v_mfma_f32_16x16x32_bf16 v[44:47], v[172:175], v[220:223], v[44:47]
    v_mfma_f32_16x16x32_bf16 v[48:51], v[176:179], v[220:223], v[48:51]
    v_mfma_f32_16x16x32_bf16 v[52:55], v[180:183], v[220:223], v[52:55]
    v_mfma_f32_16x16x32_bf16 v[56:59], v[184:187], v[220:223], v[56:59]
    v_mfma_f32_16x16x32_bf16 v[60:63], v[188:191], v[220:223], v[60:63]
    v_mfma_f32_16x16x32_bf16 v[64:67], v[192:195], v[220:223], v[64:67]
    v_mfma_f32_16x16x32_bf16 v[68:71], v[196:199], v[220:223], v[68:71]
    v_mfma_f32_16x16x32_bf16 v[72:75], v[200:203], v[220:223], v[72:75]
    v_add_u32 v224, 2048, v224
    v_add_u32 v225, 128, v225
    s_lshr_b32 s44, s44, 2
    s_add_u32 s30, s30, 32768
    s_add_u32 s31, s30, 4096
    s_sub_u32 s38, s38, 1
    s_cmp_lg_u32 s38, 0
    s_cbranch_scc1 L_vloop
    v_mul_f32 v172, v229, v44
    v_mul_f32 v173, v229, v48
    v_mul_f32 v174, v229, v52
    v_mul_f32 v175, v229, v56
    v_mul_f32 v176, v229, v60
    v_mul_f32 v177, v229, v64
    v_mul_f32 v178, v229, v68
    v_mul_f32 v179, v229, v72
    ds_write_b128 v214, v[172:175] offset:0
    ds_write_b128 v214, v[176:179] offset:16
    v_mul_f32 v180, v229, v45
    v_mul_f32 v181, v229, v49
    v_mul_f32 v182, v229, v53
    v_mul_f32 v183, v229, v57
    v_mul_f32 v184, v229, v61
    v_mul_f32 v185, v229, v65
    v_mul_f32 v186, v229, v69
    v_mul_f32 v187, v229, v73
    ds_write_b128 v214, v[180:183] offset:32
    ds_write_b128 v214, v[184:187] offset:48
    v_mul_f32 v188, v229, v46
    v_mul_f32 v189, v229, v50
    v_mul_f32 v190, v229, v54
    v_mul_f32 v191, v229, v58
    v_mul_f32 v192, v229, v62
    v_mul_f32 v193, v229, v66
    v_mul_f32 v194, v229, v70
    v_mul_f32 v195, v229, v74
    ds_write_b128 v214, v[188:191] offset:64
    ds_write_b128 v214, v[192:195] offset:80
    v_mul_f32 v196, v229, v47
    v_mul_f32 v197, v229, v51
    v_mul_f32 v198, v229, v55
    v_mul_f32 v199, v229, v59
    v_mul_f32 v200, v229, v63
    v_mul_f32 v201, v229, v67
    v_mul_f32 v202, v229, v71
    v_mul_f32 v203, v229, v75
    ds_write_b128 v214, v[196:199] offset:96
    ds_write_b128 v214, v[200:203] offset:112
    v_add_u32 v213, 65536, v217
    s_waitcnt lgkmcnt(0)
    s_barrier
    ds_read_b128 v[44:47], v217 offset:0
    ds_read_b128 v[48:51], v217 offset:16
    ds_read_b128 v[52:55], v217 offset:32768
    ds_read_b128 v[56:59], v217 offset:32784
    ds_read_b128 v[60:63], v213 offset:0
    ds_read_b128 v[64:67], v213 offset:16
    ds_read_b128 v[68:71], v213 offset:32768
    ds_read_b128 v[72:75], v213 offset:32784
    s_waitcnt lgkmcnt(4)
    v_add_f32 v92, v44, v52
    v_add_f32 v93, v45, v53
    v_add_f32 v94, v46, v54
    v_add_f32 v95, v47, v55
    v_add_f32 v96, v48, v56
    v_add_f32 v97, v49, v57
    v_add_f32 v98, v50, v58
    v_add_f32 v99, v51, v59
    s_waitcnt lgkmcnt(0)
    v_add_f32 v76, v60, v68
    v_add_f32 v77, v61, v69
    v_add_f32 v78, v62, v70
    v_add_f32 v79, v63, v71
    v_add_f32 v80, v64, v72
    v_add_f32 v81, v65, v73
    v_add_f32 v82, v66, v74
    v_add_f32 v83, v67, v75
    v_add_f32 v92, v92, v76
    v_add_f32 v93, v93, v77
    v_add_f32 v94, v94, v78
    v_add_f32 v95, v95, v79
    v_add_f32 v96, v96, v80
    v_add_f32 v97, v97, v81
    v_add_f32 v98, v98, v82
    v_add_f32 v99, v99, v83
    v_cvt_pk_bf16_f32 v20, v92, v93
    v_cvt_pk_bf16_f32 v21, v94, v95
    v_cvt_pk_bf16_f32 v22, v96, v97
    v_cvt_pk_bf16_f32 v23, v98, v99
    buffer_store_dwordx4 v[20:23], v218, s[24:27], 0 offen
L_end:
    s_endpgm
.section .rodata,"a"
.p2align 6
.amdhsa_kernel standalone__gqa_softmax__sampling_kernel
  .amdhsa_next_free_vgpr 232
  .amdhsa_next_free_sgpr 88
  .amdhsa_accum_offset 232
  .amdhsa_group_segment_fixed_size 0
  .amdhsa_kernarg_size 48
  .amdhsa_user_sgpr_count 2
  .amdhsa_user_sgpr_kernarg_segment_ptr 1
  .amdhsa_system_sgpr_workgroup_id_x 1
.end_amdhsa_kernel
```
